```python
import torch

def _softmax(x, axis=-1):
    return torch.softmax(x, dim=axis)
def _gelu(x):
    return torch.nn.functional.gelu(x, approximate="tanh")
def _silu(x):
    return torch.nn.functional.silu(x)
def _sigmoid(x):
    return torch.sigmoid(x)
def _layernorm(x, axis=-1, eps=1e-5):
    m = x.mean(dim=axis, keepdim=True)
    v = x.var(dim=axis, keepdim=True, unbiased=False)
    return (x - m) / torch.sqrt(v + eps)
def _scatter_add(tgt, idx, src, axis=0):
    return tgt.clone().index_add_(axis, idx, src)
def _segment_sum(src, seg, n):
    out = torch.zeros((n,) + src.shape[1:], dtype=src.dtype)
    return out.index_add_(0, seg, src)
def _pad(x, pw):
    flat = tuple(v for pair in reversed(pw) for v in pair)
    return torch.nn.functional.pad(x, flat)

kernel_name = 'standalone__sliding_local_strided__prompt'

def setup_inputs():

    _w = (lambda a: (lambda t: t.to(torch.bfloat16) if t.is_floating_point() else t)(torch.as_tensor(a)))
    B, H, S, D = 1, 32, 2048, 192
    return {
        "q": _w((lambda *s: torch.randn(*s, dtype=torch.bfloat16) * 0.8)(B, H, S, D)),
        "k": _w((lambda *s: torch.randn(*s, dtype=torch.bfloat16) * 0.8)(B, H, S, D)),
        "v": _w((lambda *s: torch.randn(*s, dtype=torch.bfloat16) * 0.05)(B, H, S, D)),
    }

def reference(q, k, v):
    B, H, S, D = q.shape
    W, dil = 8, 4
    scale = D ** -0.5
    pos = torch.arange(S)
    kidx = pos[:, None] - torch.arange(W)[None, :] * dil
    valid = kidx >= 0
    kidx = torch.where(valid, kidx, torch.zeros_like(kidx))
    idx = torch.reshape(kidx, (1, 1, S * W, 1))
    idx = (lambda x, n, axis: torch.repeat_interleave(x, n, dim=axis))(idx, B, 0)
    idx = (lambda x, n, axis: torch.repeat_interleave(x, n, dim=axis))(idx, H, 1)
    idx = (lambda x, n, axis: torch.repeat_interleave(x, n, dim=axis))(idx, D, 3)
    kg = torch.reshape((lambda x, i, axis: torch.take_along_dim(x, i, dim=axis))(k, idx, 2), (B, H, S, W, D))
    vg = torch.reshape((lambda x, i, axis: torch.take_along_dim(x, i, dim=axis))(v, idx, 2), (B, H, S, W, D))
    scores = torch.einsum("bhsd,bhswd->bhsw", q, kg) * scale
    mask_f = (lambda x, dt: x.to(dt))(valid, q.dtype)[None, None, :, :]
    scores = scores + (mask_f - 1.0) * 1e9
    p = _softmax(scores, axis=-1)
    return torch.einsum("bhsw,bhswd->bhsd", p, vg)
```

```asm
; @launch grid=(256,1,1) block=(1024,1,1) lds=160000
.amdgcn_target "amdgcn-amd-amdhsa--gfx950"
.text
.globl standalone__sliding_local_strided__prompt_kernel
.p2align 8
.type standalone__sliding_local_strided__prompt_kernel,@function
standalone__sliding_local_strided__prompt_kernel:
    s_cmp_ge_u32 s2, 256
    s_cbranch_scc1 L_end
    s_load_dwordx2 s[16:17], s[0:1], 8
    s_load_dwordx2 s[20:21], s[0:1], 16
    s_load_dwordx2 s[12:13], s[0:1], 0
    s_load_dwordx2 s[24:25], s[0:1], 24
    s_mov_b32 s18, 25165824
    s_mov_b32 s19, 0x00020000
    s_mov_b32 s22, 25165824
    s_mov_b32 s23, 0x00020000
    s_mov_b32 s14, 25165824
    s_mov_b32 s15, 0x00020000
    s_mov_b32 s26, 25165824
    s_mov_b32 s27, 0x00020000
    v_lshrrev_b32 v2, 6, v0
    v_and_b32 v1, 63, v0
    v_readfirstlane_b32 s28, v2
    v_lshlrev_b32 v8, 3, v2
    v_add_u32 v8, 159744, v8
    v_mov_b32 v28, 0
    v_mov_b32 v29, 0
    ds_write_b64 v8, v[28:29]
    s_and_b32 s29, s2, 7
    s_lshl_b32 s29, s29, 5
    s_lshr_b32 s36, s2, 3
    s_add_u32 s29, s29, s36
    s_lshl_b32 s29, s29, 2
    s_lshr_b32 s35, s28, 2
    s_and_b32 s37, s28, 3
    s_add_u32 s29, s29, s35
    s_and_b32 s30, s29, 31
    s_mul_i32 s32, s29, 24576
    s_mul_i32 s36, s37, 384
    s_add_u32 s32, s32, s36
    s_add_u32 s33, s32, 12288
    s_sub_u32 s31, s32, 12288
    s_cmp_eq_u32 s30, 0
    s_cselect_b32 s31, s32, s31
    s_cselect_b32 s34, 64, 8
    v_lshrrev_b32 v30, 3, v1
    v_and_b32 v31, 7, v1
    v_and_b32 v9, 6, v30
    v_xor_b32 v9, v9, v31
    v_lshlrev_b32 v9, 4, v9
    v_mul_u32_u24 v10, 1536, v30
    v_add_u32 v2, v10, v9
    v_cmp_gt_u32 vcc, s34, v1
    v_or_b32 v3, 0x40000000, v2
    v_lshlrev_b32 v4, 4, v1
    v_cndmask_b32 v3, v2, v3, vcc
    s_waitcnt lgkmcnt(0)
    s_cmp_eq_u32 s35, 0
    s_cbranch_scc1 L_halo
    s_barrier
    s_branch L_nohalo
L_halo:
    buffer_load_dwordx4 v[104:107], v3, s[16:19], s31 offen
    buffer_load_dwordx4 v[108:111], v3, s[16:19], s31 offen offset:128
    buffer_load_dwordx4 v[112:115], v3, s[16:19], s31 offen offset:256
    buffer_load_dwordx4 v[116:119], v3, s[20:23], s31 offen
    buffer_load_dwordx4 v[120:123], v3, s[20:23], s31 offen offset:128
    buffer_load_dwordx4 v[124:127], v3, s[20:23], s31 offen offset:256
L_nohalo:
    buffer_load_dwordx4 v[32:35], v2, s[16:19], s32 offen nt
    buffer_load_dwordx4 v[36:39], v2, s[16:19], s32 offen offset:128 nt
    buffer_load_dwordx4 v[40:43], v2, s[16:19], s32 offen offset:256 nt
    buffer_load_dwordx4 v[44:47], v2, s[16:19], s33 offen nt
    buffer_load_dwordx4 v[48:51], v2, s[16:19], s33 offen offset:128 nt
    buffer_load_dwordx4 v[52:55], v2, s[16:19], s33 offen offset:256 nt
    buffer_load_dwordx4 v[56:59], v2, s[12:15], s32 offen nt
    buffer_load_dwordx4 v[60:63], v2, s[12:15], s32 offen offset:128 nt
    buffer_load_dwordx4 v[64:67], v2, s[12:15], s32 offen offset:256 nt
    buffer_load_dwordx4 v[68:71], v2, s[12:15], s33 offen nt
    buffer_load_dwordx4 v[72:75], v2, s[12:15], s33 offen offset:128 nt
    buffer_load_dwordx4 v[76:79], v2, s[12:15], s33 offen offset:256 nt
    buffer_load_dwordx4 v[80:83], v2, s[20:23], s32 offen nt
    buffer_load_dwordx4 v[84:87], v2, s[20:23], s32 offen offset:128 nt
    buffer_load_dwordx4 v[88:91], v2, s[20:23], s32 offen offset:256 nt
    buffer_load_dwordx4 v[92:95], v2, s[20:23], s33 offen nt
    buffer_load_dwordx4 v[96:99], v2, s[20:23], s33 offen offset:128 nt
    buffer_load_dwordx4 v[100:103], v2, s[20:23], s33 offen offset:256 nt
    s_cmp_lg_u32 s35, 0
    s_cbranch_scc1 L_eg0
    s_barrier
L_eg0:
    s_getreg_b32 s62, hwreg(HW_REG_XCC_ID)
    s_and_b32 s62, s62, 1
    s_lshl_b32 s62, s62, 2
    s_or_b32 s62, s62, s35
    s_mul_i32 s36, s37, 39936
    s_mul_i32 s61, s35, 3072
    s_add_u32 s39, s36, s61
    s_add_u32 s59, s39, 3072
    s_add_u32 s38, s39, 27648
    s_sub_u32 s58, s36, s61
    s_add_u32 s58, s58, 21504
    s_add_u32 s60, s58, 3072
    v_lshrrev_b32 v20, 4, v1
    v_and_b32 v21, 15, v1
    v_and_b32 v28, 7, v21
    v_lshlrev_b32 v28, 7, v28
    v_and_b32 v29, 6, v21
    v_xor_b32 v29, v29, v20
    v_lshl_add_u32 v5, v29, 4, v28
    v_and_b32 v29, 7, v21
    v_xor_b32 v29, v29, v20
    v_lshl_add_u32 v7, v29, 4, v28
    v_lshrrev_b32 v29, 3, v21
    v_lshlrev_b32 v29, 10, v29
    v_add3_u32 v7, v7, v29, s38
    v_lshrrev_b32 v30, 2, v1
    v_and_b32 v28, 7, v30
    v_lshlrev_b32 v28, 7, v28
    v_and_b32 v29, 6, v30
    v_and_b32 v31, 3, v1
    v_xor_b32 v29, v29, v31
    v_lshl_add_u32 v6, v29, 4, v28
    v_and_b32 v28, 8, v1
    v_lshlrev_b32 v28, 1, v28
    v_xor_b32 v2, v2, v28
    v_lshlrev_b32 v28, 2, v20
    v_sub_u32 v28, v21, v28
    v_add_u32 v29, 8, v28
    s_cmp_eq_u32 s30, 0
    s_cselect_b32 s36, 0, 32
    v_cmp_gt_u32 vcc, s36, v1
    v_mov_b32 v30, 1000
    s_mov_b32 s56, 0x3d93cd3a
    v_cndmask_b32 v29, v30, v29, vcc
    v_subrev_u32 v30, 0, v29
    v_cmp_ge_u32 s[40:41], 7, v30
    v_subrev_u32 v31, 0, v28
    v_cmp_ge_u32 s[48:49], 7, v31
    v_subrev_u32 v30, 1, v29
    v_cmp_ge_u32 s[42:43], 7, v30
    v_subrev_u32 v31, 1, v28
    v_cmp_ge_u32 s[50:51], 7, v31
    v_subrev_u32 v30, 2, v29
    v_cmp_ge_u32 s[44:45], 7, v30
    v_subrev_u32 v31, 2, v28
    v_cmp_ge_u32 s[52:53], 7, v31
    v_subrev_u32 v30, 3, v29
    v_cmp_ge_u32 s[46:47], 7, v30
    v_subrev_u32 v31, 3, v28
    v_cmp_ge_u32 s[54:55], 7, v31
    s_mov_b32 s57, 0x3fb8aa3b
    v_cmp_gt_u32 vcc, 8, v21
    v_mov_b32 v28, s59
    v_mov_b32 v29, s38
    v_cndmask_b32 v28, v28, v29, vcc
    v_add_u32 v11, v28, v5
    v_xor_b32 v12, 64, v11
    v_add_u32 v9, s39, v4
    v_add_u32 v10, s38, v4
    v_add_u32 v30, s58, v4
    v_mov_b32 v31, 1
    s_cmp_lg_u32 s35, 0
    s_cbranch_scc1 L_nohalo2
    s_waitcnt vmcnt(18)
    ds_write_b128 v9, v[104:107] offset:0
    ds_write_b128 v9, v[108:111] offset:1024
    ds_write_b128 v9, v[112:115] offset:2048
    ds_write_b128 v30, v[116:119] offset:3072
    ds_write_b128 v30, v[120:123] offset:4096
    ds_write_b128 v30, v[124:127] offset:5120
L_nohalo2:
    s_waitcnt vmcnt(17)
    ds_write_b128 v10, v[32:35] offset:0
    s_waitcnt vmcnt(16)
    ds_write_b128 v10, v[36:39] offset:1024
    s_waitcnt vmcnt(15)
    ds_write_b128 v10, v[40:43] offset:2048
    s_waitcnt vmcnt(14)
    ds_write_b128 v9, v[44:47] offset:3072
    s_waitcnt vmcnt(13)
    ds_write_b128 v9, v[48:51] offset:4096
    s_waitcnt vmcnt(12)
    ds_write_b128 v9, v[52:55] offset:5120
    ds_read_b128 v[32:35], v11 offset:0
    ds_read_b128 v[36:39], v12 offset:0
    ds_read_b128 v[40:43], v11 offset:1024
    ds_read_b128 v[44:47], v12 offset:1024
    ds_read_b128 v[48:51], v11 offset:2048
    ds_read_b128 v[52:55], v12 offset:2048
    s_waitcnt lgkmcnt(6)
    ds_write_b32 v8, v31
    v_and_b32 v28, 8, v1
    v_lshlrev_b32 v28, 7, v28
    v_add3_u32 v11, v28, v5, s38
    v_xor_b32 v12, 64, v11
    s_waitcnt vmcnt(11)
    ds_write_b128 v10, v[56:59]
    s_waitcnt vmcnt(8)
    ds_write_b128 v10, v[68:71] offset:1024
    ds_read_b128 v[56:59], v11
    ds_read_b128 v[68:71], v12
    s_waitcnt vmcnt(10)
    ds_write_b128 v10, v[60:63]
    s_waitcnt vmcnt(7)
    ds_write_b128 v10, v[72:75] offset:1024
    ds_read_b128 v[60:63], v11
    ds_read_b128 v[72:75], v12
    s_waitcnt vmcnt(9)
    ds_write_b128 v10, v[64:67]
    s_waitcnt vmcnt(6)
    ds_write_b128 v10, v[76:79] offset:1024
    ds_read_b128 v[64:67], v11
    ds_read_b128 v[76:79], v12
    v_add_u32 v11, s39, v5
    v_xor_b32 v12, 64, v11
    s_cmp_eq_u32 s35, 0
    s_cbranch_scc1 L_wk_ok
    v_subrev_u32 v28, 32, v8
L_wk:
    ds_read_b32 v29, v28 offset:0
    s_waitcnt lgkmcnt(0)
    v_readfirstlane_b32 s36, v29
    s_cmp_eq_u32 s36, 0
    s_cbranch_scc1 L_wk
L_wk_ok:
    ds_read_b128 v[104:107], v11 offset:0
    ds_read_b128 v[108:111], v12 offset:0
    ds_read_b128 v[112:115], v11 offset:1024
    ds_read_b128 v[116:119], v12 offset:1024
    ds_read_b128 v[120:123], v11 offset:2048
    ds_read_b128 v[124:127], v12 offset:2048
    s_waitcnt lgkmcnt(6)
    v_mfma_f32_16x16x32_bf16 v[24:27], v[32:35], v[56:59], 0
    v_mfma_f32_16x16x32_bf16 v[24:27], v[36:39], v[68:71], v[24:27]
    v_mfma_f32_16x16x32_bf16 v[24:27], v[40:43], v[60:63], v[24:27]
    v_mfma_f32_16x16x32_bf16 v[24:27], v[44:47], v[72:75], v[24:27]
    v_mfma_f32_16x16x32_bf16 v[24:27], v[48:51], v[64:67], v[24:27]
    v_mfma_f32_16x16x32_bf16 v[24:27], v[52:55], v[76:79], v[24:27]
    s_waitcnt lgkmcnt(5)
    v_mfma_f32_16x16x32_bf16 v[20:23], v[104:107], v[56:59], 0
    s_waitcnt lgkmcnt(4)
    v_mfma_f32_16x16x32_bf16 v[20:23], v[108:111], v[68:71], v[20:23]
    s_waitcnt lgkmcnt(3)
    v_mfma_f32_16x16x32_bf16 v[20:23], v[112:115], v[60:63], v[20:23]
    s_waitcnt lgkmcnt(2)
    v_mfma_f32_16x16x32_bf16 v[20:23], v[116:119], v[72:75], v[20:23]
    s_waitcnt lgkmcnt(1)
    v_mfma_f32_16x16x32_bf16 v[20:23], v[120:123], v[64:67], v[20:23]
    s_waitcnt lgkmcnt(0)
    v_mfma_f32_16x16x32_bf16 v[20:23], v[124:127], v[76:79], v[20:23]
    s_cmp_lg_u32 s62, 7
    s_cbranch_scc1 L_nb0
    s_barrier
L_nb0:
    v_cmp_gt_u32 vcc, 32, v1
    v_mov_b32 v28, s58
    v_mov_b32 v29, s38
    v_cndmask_b32 v28, v28, v29, vcc
    v_add_u32 v11, v28, v6
    v_xor_b32 v12, 64, v11
    v_add_u32 v9, s60, v6
    s_waitcnt vmcnt(5)
    ds_write_b128 v10, v[80:83] offset:0
    s_waitcnt vmcnt(4)
    ds_write_b128 v10, v[84:87] offset:1024
    s_waitcnt vmcnt(3)
    ds_write_b128 v10, v[88:91] offset:2048
    s_waitcnt vmcnt(2)
    ds_write_b128 v30, v[92:95] offset:0
    s_waitcnt vmcnt(1)
    ds_write_b128 v30, v[96:99] offset:1024
    s_waitcnt vmcnt(0)
    ds_write_b128 v30, v[100:103] offset:2048
    v_xor_b32 v30, 64, v9
    ds_read_b64_tr_b16 v[82:83], v11 offset:0
    ds_read_b64_tr_b16 v[86:87], v11 offset:8
    ds_read_b64_tr_b16 v[90:91], v12 offset:0
    ds_read_b64_tr_b16 v[94:95], v12 offset:8
    ds_read_b64_tr_b16 v[98:99], v11 offset:1024
    ds_read_b64_tr_b16 v[102:103], v11 offset:1032
    ds_read_b64_tr_b16 v[106:107], v12 offset:1024
    ds_read_b64_tr_b16 v[110:111], v12 offset:1032
    ds_read_b64_tr_b16 v[114:115], v11 offset:2048
    ds_read_b64_tr_b16 v[118:119], v11 offset:2056
    ds_read_b64_tr_b16 v[122:123], v12 offset:2048
    ds_read_b64_tr_b16 v[126:127], v12 offset:2056
    s_waitcnt lgkmcnt(12)
    ds_write_b32 v8, v31 offset:4
    s_cmp_eq_u32 s35, 0
    s_cbranch_scc1 L_wv_ok
    v_subrev_u32 v28, 32, v8
L_wv:
    ds_read_b32 v29, v28 offset:4
    s_waitcnt lgkmcnt(0)
    v_readfirstlane_b32 s36, v29
    s_cmp_eq_u32 s36, 0
    s_cbranch_scc1 L_wv
L_wv_ok:
    ds_read_b64_tr_b16 v[80:81], v9 offset:0
    ds_read_b64_tr_b16 v[84:85], v9 offset:8
    ds_read_b64_tr_b16 v[88:89], v30 offset:0
    ds_read_b64_tr_b16 v[92:93], v30 offset:8
    ds_read_b64_tr_b16 v[96:97], v9 offset:1024
    ds_read_b64_tr_b16 v[100:101], v9 offset:1032
    ds_read_b64_tr_b16 v[104:105], v30 offset:1024
    ds_read_b64_tr_b16 v[108:109], v30 offset:1032
    ds_read_b64_tr_b16 v[112:113], v9 offset:2048
    ds_read_b64_tr_b16 v[116:117], v9 offset:2056
    ds_read_b64_tr_b16 v[120:121], v30 offset:2048
    ds_read_b64_tr_b16 v[124:125], v30 offset:2056
    v_cvt_pk_bf16_f32 v16, v20, v21
    v_cvt_pk_bf16_f32 v17, v22, v23
    v_cvt_pk_bf16_f32 v18, v24, v25
    v_cvt_pk_bf16_f32 v19, v26, v27
    v_lshlrev_b32 v20, 16, v16
    v_and_b32 v21, 0xffff0000, v16
    v_lshlrev_b32 v22, 16, v17
    v_and_b32 v23, 0xffff0000, v17
    v_lshlrev_b32 v24, 16, v18
    v_and_b32 v25, 0xffff0000, v18
    v_lshlrev_b32 v26, 16, v19
    v_and_b32 v27, 0xffff0000, v19
    v_mul_f32 v20, s56, v20
    v_mul_f32 v21, s56, v21
    v_mul_f32 v22, s56, v22
    v_mul_f32 v23, s56, v23
    v_mul_f32 v24, s56, v24
    v_mul_f32 v25, s56, v25
    v_mul_f32 v26, s56, v26
    v_mul_f32 v27, s56, v27
    v_cvt_pk_bf16_f32 v16, v20, v21
    v_cvt_pk_bf16_f32 v17, v22, v23
    v_cvt_pk_bf16_f32 v18, v24, v25
    v_cvt_pk_bf16_f32 v19, v26, v27
    v_lshlrev_b32 v20, 16, v16
    v_and_b32 v21, 0xffff0000, v16
    v_lshlrev_b32 v22, 16, v17
    v_and_b32 v23, 0xffff0000, v17
    v_lshlrev_b32 v24, 16, v18
    v_and_b32 v25, 0xffff0000, v18
    v_lshlrev_b32 v26, 16, v19
    v_and_b32 v27, 0xffff0000, v19
    v_mov_b32 v13, 0xff800000
    v_cndmask_b32 v20, v13, v20, s[40:41]
    v_cndmask_b32 v21, v13, v21, s[42:43]
    v_cndmask_b32 v22, v13, v22, s[44:45]
    v_cndmask_b32 v23, v13, v23, s[46:47]
    v_cndmask_b32 v24, v13, v24, s[48:49]
    v_cndmask_b32 v25, v13, v25, s[50:51]
    v_cndmask_b32 v26, v13, v26, s[52:53]
    v_cndmask_b32 v27, v13, v27, s[54:55]
    v_max3_f32 v13, v20, v21, v22
    v_max3_f32 v14, v23, v24, v25
    v_max3_f32 v13, v13, v26, v27
    v_max_f32 v13, v13, v14
    v_mov_b32 v14, v13
    s_nop 1
    v_permlane16_swap_b32 v13, v14
    s_nop 1
    v_max_f32 v13, v13, v14
    v_mov_b32 v14, v13
    s_nop 1
    v_permlane32_swap_b32 v13, v14
    s_nop 1
    v_max_f32 v13, v13, v14
    v_sub_f32 v20, v20, v13
    v_sub_f32 v21, v21, v13
    v_sub_f32 v22, v22, v13
    v_sub_f32 v23, v23, v13
    v_sub_f32 v24, v24, v13
    v_sub_f32 v25, v25, v13
    v_sub_f32 v26, v26, v13
    v_sub_f32 v27, v27, v13
    v_mul_f32 v20, s57, v20
    v_mul_f32 v21, s57, v21
    v_mul_f32 v22, s57, v22
    v_mul_f32 v23, s57, v23
    v_mul_f32 v24, s57, v24
    v_mul_f32 v25, s57, v25
    v_mul_f32 v26, s57, v26
    v_mul_f32 v27, s57, v27
    v_exp_f32 v20, v20
    v_exp_f32 v21, v21
    v_exp_f32 v22, v22
    v_exp_f32 v23, v23
    v_exp_f32 v24, v24
    v_exp_f32 v25, v25
    v_exp_f32 v26, v26
    v_exp_f32 v27, v27
    s_nop 0
    v_add_f32 v13, v20, v21
    v_add_f32 v14, v22, v23
    v_add_f32 v15, v24, v25
    v_add_f32 v28, v26, v27
    v_add_f32 v13, v13, v14
    v_add_f32 v15, v15, v28
    v_add_f32 v13, v13, v15
    v_mov_b32 v14, v13
    s_nop 1
    v_permlane16_swap_b32 v13, v14
    s_nop 1
    v_add_f32 v13, v13, v14
    v_mov_b32 v14, v13
    s_nop 1
    v_permlane32_swap_b32 v13, v14
    s_nop 1
    v_add_f32 v13, v13, v14
    v_rcp_f32 v13, v13
    s_nop 0
    v_mul_f32 v20, v20, v13
    v_mul_f32 v21, v21, v13
    v_mul_f32 v22, v22, v13
    v_mul_f32 v23, v23, v13
    v_mul_f32 v24, v24, v13
    v_mul_f32 v25, v25, v13
    v_mul_f32 v26, v26, v13
    v_mul_f32 v27, v27, v13
    v_cvt_pk_bf16_f32 v16, v20, v21
    v_cvt_pk_bf16_f32 v17, v22, v23
    v_cvt_pk_bf16_f32 v18, v24, v25
    v_cvt_pk_bf16_f32 v19, v26, v27
    v_xor_b32 v12, 64, v7
    s_nop 0
    s_waitcnt lgkmcnt(11)
    v_mfma_f32_16x16x32_bf16 v[32:35], v[80:83], v[16:19], 0
    s_waitcnt lgkmcnt(10)
    v_mfma_f32_16x16x32_bf16 v[36:39], v[84:87], v[16:19], 0
    s_waitcnt lgkmcnt(9)
    v_mfma_f32_16x16x32_bf16 v[40:43], v[88:91], v[16:19], 0
    s_waitcnt lgkmcnt(8)
    v_mfma_f32_16x16x32_bf16 v[44:47], v[92:95], v[16:19], 0
    s_waitcnt lgkmcnt(7)
    v_mfma_f32_16x16x32_bf16 v[48:51], v[96:99], v[16:19], 0
    s_waitcnt lgkmcnt(6)
    v_mfma_f32_16x16x32_bf16 v[52:55], v[100:103], v[16:19], 0
    s_waitcnt lgkmcnt(5)
    v_mfma_f32_16x16x32_bf16 v[56:59], v[104:107], v[16:19], 0
    s_waitcnt lgkmcnt(4)
    v_mfma_f32_16x16x32_bf16 v[60:63], v[108:111], v[16:19], 0
    s_waitcnt lgkmcnt(3)
    v_mfma_f32_16x16x32_bf16 v[64:67], v[112:115], v[16:19], 0
    s_waitcnt lgkmcnt(2)
    v_mfma_f32_16x16x32_bf16 v[68:71], v[116:119], v[16:19], 0
    s_waitcnt lgkmcnt(1)
    v_mfma_f32_16x16x32_bf16 v[72:75], v[120:123], v[16:19], 0
    s_waitcnt lgkmcnt(0)
    v_mfma_f32_16x16x32_bf16 v[76:79], v[124:127], v[16:19], 0
    s_nop 7
    s_cmp_lg_u32 s62, 3
    s_cbranch_scc1 L_nb1
    s_barrier
L_nb1:
    v_cvt_pk_bf16_f32 v32, v32, v33
    v_cvt_pk_bf16_f32 v33, v34, v35
    v_cvt_pk_bf16_f32 v34, v36, v37
    v_cvt_pk_bf16_f32 v35, v38, v39
    ds_write_b128 v7, v[32:35]
    v_cvt_pk_bf16_f32 v40, v40, v41
    v_cvt_pk_bf16_f32 v41, v42, v43
    v_cvt_pk_bf16_f32 v42, v44, v45
    v_cvt_pk_bf16_f32 v43, v46, v47
    ds_write_b128 v12, v[40:43]
    ds_read_b128 v[80:83], v10
    ds_read_b128 v[92:95], v10 offset:1024
    v_cvt_pk_bf16_f32 v48, v48, v49
    v_cvt_pk_bf16_f32 v49, v50, v51
    v_cvt_pk_bf16_f32 v50, v52, v53
    v_cvt_pk_bf16_f32 v51, v54, v55
    ds_write_b128 v7, v[48:51]
    v_cvt_pk_bf16_f32 v56, v56, v57
    v_cvt_pk_bf16_f32 v57, v58, v59
    v_cvt_pk_bf16_f32 v58, v60, v61
    v_cvt_pk_bf16_f32 v59, v62, v63
    ds_write_b128 v12, v[56:59]
    ds_read_b128 v[84:87], v10
    ds_read_b128 v[96:99], v10 offset:1024
    v_cvt_pk_bf16_f32 v64, v64, v65
    v_cvt_pk_bf16_f32 v65, v66, v67
    v_cvt_pk_bf16_f32 v66, v68, v69
    v_cvt_pk_bf16_f32 v67, v70, v71
    ds_write_b128 v7, v[64:67]
    v_cvt_pk_bf16_f32 v72, v72, v73
    v_cvt_pk_bf16_f32 v73, v74, v75
    v_cvt_pk_bf16_f32 v74, v76, v77
    v_cvt_pk_bf16_f32 v75, v78, v79
    ds_write_b128 v12, v[72:75]
    ds_read_b128 v[88:91], v10
    ds_read_b128 v[100:103], v10 offset:1024
    s_cmp_eq_u32 s35, 3
    s_cbranch_scc1 L_st
    s_barrier
L_st:
    s_waitcnt lgkmcnt(0)
    s_cmp_ge_u32 s35, 3
    s_cbranch_scc1 L_st3
    buffer_store_dwordx4 v[80:83], v2, s[24:27], s32 offen nt
    buffer_store_dwordx4 v[84:87], v2, s[24:27], s32 offen offset:128 nt
    buffer_store_dwordx4 v[88:91], v2, s[24:27], s32 offen offset:256 nt
    buffer_store_dwordx4 v[92:95], v2, s[24:27], s33 offen nt
    buffer_store_dwordx4 v[96:99], v2, s[24:27], s33 offen offset:128 nt
    buffer_store_dwordx4 v[100:103], v2, s[24:27], s33 offen offset:256 nt
    s_branch L_stdone
L_st3:
    buffer_store_dwordx4 v[80:83], v2, s[24:27], s32 offen sc1
    buffer_store_dwordx4 v[84:87], v2, s[24:27], s32 offen offset:128 sc1
    buffer_store_dwordx4 v[88:91], v2, s[24:27], s32 offen offset:256 sc1
    buffer_store_dwordx4 v[92:95], v2, s[24:27], s33 offen sc1
    buffer_store_dwordx4 v[96:99], v2, s[24:27], s33 offen offset:128 sc1
    buffer_store_dwordx4 v[100:103], v2, s[24:27], s33 offen offset:256 sc1
L_stdone:
L_end:
    s_endpgm
.section .rodata,"a"
.p2align 6
.amdhsa_kernel standalone__sliding_local_strided__prompt_kernel
  .amdhsa_next_free_vgpr 128
  .amdhsa_next_free_sgpr 64
  .amdhsa_accum_offset 128
  .amdhsa_group_segment_fixed_size 0
  .amdhsa_kernarg_size 48
  .amdhsa_user_sgpr_count 2
  .amdhsa_user_sgpr_kernarg_segment_ptr 1
  .amdhsa_system_sgpr_workgroup_id_x 1
.end_amdhsa_kernel
```
